```python
import torch

def _softmax(x, axis=-1):
    return torch.softmax(x, dim=axis)
def _gelu(x):
    return torch.nn.functional.gelu(x, approximate="tanh")
def _silu(x):
    return torch.nn.functional.silu(x)
def _sigmoid(x):
    return torch.sigmoid(x)
def _layernorm(x, axis=-1, eps=1e-5):
    m = x.mean(dim=axis, keepdim=True)
    v = x.var(dim=axis, keepdim=True, unbiased=False)
    return (x - m) / torch.sqrt(v + eps)
def _scatter_add(tgt, idx, src, axis=0):
    return tgt.clone().index_add_(axis, idx, src)
def _segment_sum(src, seg, n):
    out = torch.zeros((n,) + src.shape[1:], dtype=src.dtype)
    return out.index_add_(0, seg, src)
def _pad(x, pw):
    flat = tuple(v for pair in reversed(pw) for v in pair)
    return torch.nn.functional.pad(x, flat)

kernel_name = 'standalone__sliding_block_cached__decode'

def setup_inputs():

    _w = (lambda a: (lambda t: t.to(torch.bfloat16) if t.is_floating_point() else t)(torch.as_tensor(a)))
    B, Sq, D = 4, 1, 512
    Hq, Hkv, Sk, Dh = 32, 8, 4096, 128
    assert Hq % Hkv == 0, (Hq, Hkv)
    return {
        "x": _w((lambda *s: torch.randn(*s, dtype=torch.bfloat16) * 0.8)(B, Sq, D)),
        "k_cache": _w((lambda *s: torch.randn(*s, dtype=torch.bfloat16) * 0.8)(B, Hkv, Sk, Dh)),
        "v_cache": _w((lambda *s: torch.randn(*s, dtype=torch.bfloat16) * 0.05)(B, Hkv, Sk, Dh)),
        "wq": _w((lambda *s: torch.randn(*s, dtype=torch.bfloat16) * 0.8)(D, Hq * Dh) * (D ** -0.5)),
        "wo": _w((lambda *s: torch.randn(*s, dtype=torch.bfloat16) * 0.05)(Hq * Dh, D) * ((Hq * Dh) ** -0.5)),
    }

def reference(x, k_cache, v_cache, wq, wo):
    B, Sq, D = x.shape
    Hq, Dh = 32, 128
    Hkv, Sk = k_cache.shape[1], k_cache.shape[2]
    W = min(4096, max(256, Sk // 4))
    rep = Hq // Hkv
    q = (lambda x, *d: x.permute(*d))((x @ wq).reshape(B, Sq, Hq, Dh), 0, 2, 1, 3)
    k = (lambda x, n, axis: torch.repeat_interleave(x, n, dim=axis))(k_cache[:, :, Sk - W:, :], rep, axis=1)
    v = (lambda x, n, axis: torch.repeat_interleave(x, n, dim=axis))(v_cache[:, :, Sk - W:, :], rep, axis=1)
    scores = torch.einsum("bhqd,bhkd->bhqk", q, k) * (Dh ** -0.5)
    p = _softmax(scores, axis=-1)
    o = torch.einsum("bhqk,bhkd->bhqd", p, v)
    return (lambda x, *d: x.permute(*d))(o, 0, 2, 1, 3).reshape(B, Sq, Hq * Dh) @ wo
```

```asm
; @launch grid=(256,1,1) block=(320,1,1) lds=103168
.amdgcn_target "amdgcn-amd-amdhsa--gfx950"
.text
.globl standalone__sliding_block_cached__decode_kernel
.p2align 8
.type standalone__sliding_block_cached__decode_kernel,@function
standalone__sliding_block_cached__decode_kernel:
    s_cmp_ge_u32 s2, 256
    s_cbranch_scc1 L_end
    s_load_dwordx2 s[20:21], s[0:1], 24
    s_load_dwordx2 s[8:9], s[0:1], 0
    s_load_dwordx2 s[12:13], s[0:1], 8
    s_load_dwordx2 s[28:29], s[0:1], 56
    s_load_dwordx2 s[16:17], s[0:1], 16
    s_load_dwordx2 s[24:25], s[0:1], 32
    s_load_dwordx2 s[32:33], s[0:1], 40
    v_lshrrev_b32 v2, 6, v0
    v_and_b32 v1, 63, v0
    s_and_b32 s4, s2, 7
    v_readfirstlane_b32 s3, v2
    s_lshr_b32 s5, s2, 3
    s_lshr_b32 s6, s5, 3
    s_and_b32 s7, s5, 7
    s_mov_b32 s23, 0x20000
    v_lshrrev_b32 v2, 4, v1
    v_and_b32 v3, 15, v1
    s_cmp_lt_u32 s3, 4
    s_cbranch_scc1 L_compute
    s_setprio 2
    s_mov_b32 s22, 0x400000
    v_and_b32 v4, 7, v1
    v_lshlrev_b32 v5, 1, v2
    v_and_b32 v8, 2, v5
    v_xor_b32 v4, v4, v8
    v_lshlrev_b32 v4, 4, v4
    v_lshrrev_b32 v8, 3, v1
    v_lshl_add_u32 v6, v8, 13, v4
    v_xor_b32 v7, 64, v6
    s_lshl_b32 s44, s4, 3
    s_xor_b32 s43, s7, 0
    s_add_u32 s44, s44, s43
    s_lshl_b32 s44, s44, 7
    s_lshl_b32 s43, s6, 20
    s_add_u32 s44, s44, s43
    s_mov_b32 s11, s23
    s_movk_i32 s10, 0x1000
    s_mov_b32 s15, s23
    s_mov_b32 s14, 0x2000000
    v_lshlrev_b32 v4, 2, v2
    v_xor_b32 v4, v3, v4
    v_lshlrev_b32 v4, 4, v4
    v_lshl_add_u32 v8, v2, 10, v4
    s_lshl_b32 s40, s6, 8
    s_add_u32 s46, s6, 0
    s_and_b32 s46, s46, 3
    s_lshl_b32 s43, s46, 18
    s_add_u32 s39, s44, s43
    s_lshl_b32 s43, s46, 12
    s_add_u32 m0, s43, 4864
    s_nop 0
    s_waitcnt lgkmcnt(0)
    buffer_load_dwordx4 v6, s[20:23], s39 offen offset:0 nt lds
    s_add_u32 s39, s39, 64512
    buffer_load_dwordx4 v7, s[20:23], s39 offen offset:1024 nt lds
    s_add_u32 s39, s39, 64512
    buffer_load_dwordx4 v6, s[20:23], s39 offen offset:2048 nt lds
    s_add_u32 s39, s39, 64512
    buffer_load_dwordx4 v7, s[20:23], s39 offen offset:3072 nt lds
    s_add_u32 s46, s6, 1
    s_and_b32 s46, s46, 3
    s_lshl_b32 s43, s46, 18
    s_add_u32 s39, s44, s43
    s_lshl_b32 s43, s46, 12
    s_add_u32 m0, s43, 4864
    s_nop 0
    buffer_load_dwordx4 v6, s[20:23], s39 offen offset:0 nt lds
    s_add_u32 s39, s39, 64512
    buffer_load_dwordx4 v7, s[20:23], s39 offen offset:1024 nt lds
    s_add_u32 s39, s39, 64512
    buffer_load_dwordx4 v6, s[20:23], s39 offen offset:2048 nt lds
    s_add_u32 s39, s39, 64512
    buffer_load_dwordx4 v7, s[20:23], s39 offen offset:3072 nt lds
    s_add_u32 s46, s6, 2
    s_and_b32 s46, s46, 3
    s_lshl_b32 s43, s46, 18
    s_add_u32 s39, s44, s43
    s_lshl_b32 s43, s46, 12
    s_add_u32 m0, s43, 4864
    s_nop 0
    buffer_load_dwordx4 v6, s[20:23], s39 offen offset:0 nt lds
    s_add_u32 s39, s39, 64512
    buffer_load_dwordx4 v7, s[20:23], s39 offen offset:1024 nt lds
    s_add_u32 s39, s39, 64512
    buffer_load_dwordx4 v6, s[20:23], s39 offen offset:2048 nt lds
    s_add_u32 s39, s39, 64512
    buffer_load_dwordx4 v7, s[20:23], s39 offen offset:3072 nt lds
    s_add_u32 s46, s6, 3
    s_and_b32 s46, s46, 3
    s_lshl_b32 s43, s46, 18
    s_add_u32 s39, s44, s43
    s_lshl_b32 s43, s46, 12
    s_add_u32 m0, s43, 4864
    s_nop 0
    buffer_load_dwordx4 v6, s[20:23], s39 offen offset:0 nt lds
    s_add_u32 s39, s39, 64512
    buffer_load_dwordx4 v7, s[20:23], s39 offen offset:1024 nt lds
    s_add_u32 s39, s39, 64512
    buffer_load_dwordx4 v6, s[20:23], s39 offen offset:2048 nt lds
    s_add_u32 s39, s39, 64512
    buffer_load_dwordx4 v7, s[20:23], s39 offen offset:3072 nt lds
    s_movk_i32 m0, 3840
    s_nop 0
    buffer_load_dwordx4 v8, s[8:11], s40 offen lds
    v_xor_b32 v4, v3, v2
    v_lshlrev_b32 v4, 4, v4
    v_lshl_add_u32 v9, v2, 8, v4
    v_xor_b32 v10, 64, v9
    v_xor_b32 v11, 0x80, v9
    v_xor_b32 v12, 0xc0, v9
    v_lshlrev_b32 v4, 2, v1
    v_add_u32 v4, 3296, v4
    v_cmp_eq_u32 vcc, 0, v1
    v_mov_b32 v17, 3136
    v_mov_b32 v18, 1
    v_cndmask_b32 v17, v4, v17, vcc
    s_lshl_b32 s38, s6, 3
    s_add_u32 s38, s38, s4
    s_lshl_b32 s38, s38, 5
    s_add_u32 s38, s38, 24
    s_lshl_b32 s38, s38, 15
    s_lshl_b32 s46, s7, 15
    s_add_u32 s38, s38, s46
    s_lshl_b32 s45, s6, 1
    s_add_u32 s45, s45, s4
    s_mul_i32 s45, s45, 1
    s_and_b32 s45, s45, 7
    s_lshl_b32 s45, s45, 12
    s_add_u32 s46, s45, 0
    s_and_b32 s46, s46, 0x7fff
    s_add_u32 m0, s46, 21248
    s_add_u32 s41, s38, s46
    buffer_load_dwordx4 v9, s[12:15], s41 offen offset:0 nt lds
    buffer_load_dwordx4 v10, s[12:15], s41 offen offset:1024 nt lds
    buffer_load_dwordx4 v11, s[12:15], s41 offen offset:2048 nt lds
    buffer_load_dwordx4 v12, s[12:15], s41 offen offset:3072 nt lds
    s_add_u32 s46, s45, 4096
    s_and_b32 s46, s46, 0x7fff
    s_add_u32 m0, s46, 21248
    s_add_u32 s41, s38, s46
    buffer_load_dwordx4 v9, s[12:15], s41 offen offset:0 nt lds
    s_waitcnt vmcnt(21)
    buffer_load_dwordx4 v10, s[12:15], s41 offen offset:1024 nt lds
    s_waitcnt vmcnt(21)
    buffer_load_dwordx4 v11, s[12:15], s41 offen offset:2048 nt lds
    s_waitcnt vmcnt(21)
    buffer_load_dwordx4 v12, s[12:15], s41 offen offset:3072 nt lds
    s_waitcnt vmcnt(21)
    s_add_u32 s46, s45, 8192
    s_and_b32 s46, s46, 0x7fff
    s_add_u32 m0, s46, 21248
    s_add_u32 s41, s38, s46
    buffer_load_dwordx4 v9, s[12:15], s41 offen offset:0 nt lds
    s_waitcnt vmcnt(21)
    buffer_load_dwordx4 v10, s[12:15], s41 offen offset:1024 nt lds
    s_waitcnt vmcnt(21)
    buffer_load_dwordx4 v11, s[12:15], s41 offen offset:2048 nt lds
    s_waitcnt vmcnt(21)
    buffer_load_dwordx4 v12, s[12:15], s41 offen offset:3072 nt lds
    s_waitcnt vmcnt(21)
    s_add_u32 s46, s45, 12288
    s_and_b32 s46, s46, 0x7fff
    s_add_u32 m0, s46, 21248
    s_add_u32 s41, s38, s46
    buffer_load_dwordx4 v9, s[12:15], s41 offen offset:0 nt lds
    s_waitcnt vmcnt(21)
    buffer_load_dwordx4 v10, s[12:15], s41 offen offset:1024 nt lds
    s_waitcnt vmcnt(21)
    buffer_load_dwordx4 v11, s[12:15], s41 offen offset:2048 nt lds
    s_waitcnt vmcnt(21)
    buffer_load_dwordx4 v12, s[12:15], s41 offen offset:3072 nt lds
    s_waitcnt vmcnt(21)
    s_add_u32 s46, s45, 16384
    s_and_b32 s46, s46, 0x7fff
    s_add_u32 m0, s46, 21248
    s_add_u32 s41, s38, s46
    buffer_load_dwordx4 v9, s[12:15], s41 offen offset:0 nt lds
    s_waitcnt vmcnt(21)
    buffer_load_dwordx4 v10, s[12:15], s41 offen offset:1024 nt lds
    s_waitcnt vmcnt(21)
    buffer_load_dwordx4 v11, s[12:15], s41 offen offset:2048 nt lds
    s_waitcnt vmcnt(21)
    buffer_load_dwordx4 v12, s[12:15], s41 offen offset:3072 nt lds
    s_waitcnt vmcnt(21)
    s_add_u32 s46, s45, 20480
    s_and_b32 s46, s46, 0x7fff
    s_add_u32 m0, s46, 21248
    s_add_u32 s41, s38, s46
    buffer_load_dwordx4 v9, s[12:15], s41 offen offset:0 nt lds
    s_waitcnt vmcnt(21)
    s_barrier
    buffer_load_dwordx4 v10, s[12:15], s41 offen offset:1024 nt lds
    s_waitcnt vmcnt(21)
    buffer_load_dwordx4 v11, s[12:15], s41 offen offset:2048 nt lds
    s_waitcnt vmcnt(21)
    buffer_load_dwordx4 v12, s[12:15], s41 offen offset:3072 nt lds
    s_waitcnt vmcnt(21)
    s_add_u32 s46, s45, 24576
    s_and_b32 s46, s46, 0x7fff
    s_add_u32 m0, s46, 21248
    s_add_u32 s41, s38, s46
    buffer_load_dwordx4 v9, s[12:15], s41 offen offset:0 nt lds
    s_waitcnt vmcnt(21)
    buffer_load_dwordx4 v10, s[12:15], s41 offen offset:1024 nt lds
    s_waitcnt vmcnt(21)
    buffer_load_dwordx4 v11, s[12:15], s41 offen offset:2048 nt lds
    s_waitcnt vmcnt(21)
    buffer_load_dwordx4 v12, s[12:15], s41 offen offset:3072 nt lds
    v_mov_b32 v4, 3136
    v_mov_b32 v24, 3136
L_qi:
    ds_read_b128 v[20:23], v24 offset:64
    s_waitcnt lgkmcnt(0)
    v_and_b32 v20, v20, v21
    v_and_b32 v22, v22, v23
    v_and_b32 v20, v20, v22
    v_cmp_eq_u32 vcc, 0, v20
    s_cbranch_vccnz L_qi
    s_waitcnt vmcnt(35)
    s_add_u32 s46, s45, 28672
    s_and_b32 s46, s46, 0x7fff
    s_add_u32 m0, s46, 21248
    s_add_u32 s41, s38, s46
    buffer_load_dwordx4 v9, s[12:15], s41 offen offset:0 nt lds
    s_waitcnt vmcnt(35)
    buffer_load_dwordx4 v10, s[12:15], s41 offen offset:1024 nt lds
    s_waitcnt vmcnt(35)
    buffer_load_dwordx4 v11, s[12:15], s41 offen offset:2048 nt lds
    s_waitcnt vmcnt(35)
    buffer_load_dwordx4 v12, s[12:15], s41 offen offset:3072 nt lds
    s_waitcnt vmcnt(35)
    s_mov_b32 s19, s23
    s_mov_b32 s18, s14
    v_xor_b32 v4, v3, v5
    v_lshlrev_b32 v4, 4, v4
    v_lshl_add_u32 v13, v2, 8, v4
    v_xor_b32 v14, 0x80, v13
    v_lshl_add_u32 v15, v2, 10, v4
    v_xor_b32 v16, 0x80, v15
    s_mov_b32 s27, s23
    s_mov_b32 s26, s22
    s_lshr_b32 s43, s5, 2
    s_lshl_b32 s42, s4, 3
    s_add_u32 s42, s42, s43
    s_lshl_b32 s42, s42, 8
    s_and_b32 s43, s5, 3
    s_add_u32 s42, s42, s43
    s_lshl_b32 s42, s42, 8
    s_add_u32 s46, s45, 0
    s_and_b32 s46, s46, 0x7fff
    s_add_u32 m0, s46, 54016
    s_add_u32 s41, s38, s46
    buffer_load_dwordx4 v13, s[16:19], s41 offen offset:0 nt lds
    s_waitcnt vmcnt(35)
    buffer_load_dwordx4 v14, s[16:19], s41 offen offset:1024 nt lds
    s_waitcnt vmcnt(35)
    buffer_load_dwordx4 v13, s[16:19], s41 offen offset:2048 nt lds
    s_waitcnt vmcnt(35)
    buffer_load_dwordx4 v14, s[16:19], s41 offen offset:3072 nt lds
    s_waitcnt vmcnt(35)
    s_add_u32 s46, s45, 4096
    s_and_b32 s46, s46, 0x7fff
    s_add_u32 m0, s46, 54016
    s_add_u32 s41, s38, s46
    buffer_load_dwordx4 v13, s[16:19], s41 offen offset:0 nt lds
    s_waitcnt vmcnt(35)
    buffer_load_dwordx4 v14, s[16:19], s41 offen offset:1024 nt lds
    s_waitcnt vmcnt(35)
    buffer_load_dwordx4 v13, s[16:19], s41 offen offset:2048 nt lds
    s_waitcnt vmcnt(35)
    buffer_load_dwordx4 v14, s[16:19], s41 offen offset:3072 nt lds
    s_waitcnt vmcnt(35)
    s_add_u32 s46, s45, 8192
    s_and_b32 s46, s46, 0x7fff
    s_add_u32 m0, s46, 54016
    s_add_u32 s41, s38, s46
    buffer_load_dwordx4 v13, s[16:19], s41 offen offset:0 nt lds
    s_waitcnt vmcnt(35)
    buffer_load_dwordx4 v14, s[16:19], s41 offen offset:1024 nt lds
    s_waitcnt vmcnt(35)
    buffer_load_dwordx4 v13, s[16:19], s41 offen offset:2048 nt lds
    s_waitcnt vmcnt(35)
    buffer_load_dwordx4 v14, s[16:19], s41 offen offset:3072 nt lds
    s_waitcnt vmcnt(35)
    s_add_u32 s46, s45, 12288
    s_and_b32 s46, s46, 0x7fff
    s_add_u32 m0, s46, 54016
    s_add_u32 s41, s38, s46
    buffer_load_dwordx4 v13, s[16:19], s41 offen offset:0 nt lds
    s_waitcnt vmcnt(35)
    buffer_load_dwordx4 v14, s[16:19], s41 offen offset:1024 nt lds
    s_waitcnt vmcnt(35)
    buffer_load_dwordx4 v13, s[16:19], s41 offen offset:2048 nt lds
    s_waitcnt vmcnt(35)
    buffer_load_dwordx4 v14, s[16:19], s41 offen offset:3072 nt lds
    s_waitcnt vmcnt(35)
    s_add_u32 s46, s45, 16384
    s_and_b32 s46, s46, 0x7fff
    s_add_u32 m0, s46, 54016
    s_add_u32 s41, s38, s46
    buffer_load_dwordx4 v13, s[16:19], s41 offen offset:0 nt lds
    s_waitcnt vmcnt(35)
    buffer_load_dwordx4 v14, s[16:19], s41 offen offset:1024 nt lds
    s_waitcnt vmcnt(35)
    buffer_load_dwordx4 v13, s[16:19], s41 offen offset:2048 nt lds
    s_waitcnt vmcnt(35)
    buffer_load_dwordx4 v14, s[16:19], s41 offen offset:3072 nt lds
    s_waitcnt vmcnt(35)
    s_add_u32 s46, s45, 20480
    s_and_b32 s46, s46, 0x7fff
    s_add_u32 m0, s46, 54016
    s_add_u32 s41, s38, s46
    buffer_load_dwordx4 v13, s[16:19], s41 offen offset:0 nt lds
    s_waitcnt vmcnt(35)
    buffer_load_dwordx4 v14, s[16:19], s41 offen offset:1024 nt lds
    s_waitcnt vmcnt(35)
    buffer_load_dwordx4 v13, s[16:19], s41 offen offset:2048 nt lds
    s_waitcnt vmcnt(35)
    buffer_load_dwordx4 v14, s[16:19], s41 offen offset:3072 nt lds
    s_waitcnt vmcnt(19)
    ds_write_b32 v17, v18 offset:128
L_gi:
    ds_read_b128 v[20:23], v24 offset:48
    s_waitcnt lgkmcnt(0)
    v_and_b32 v20, v20, v21
    v_and_b32 v22, v22, v23
    v_and_b32 v20, v20, v22
    v_cmp_eq_u32 vcc, 0, v20
    s_cbranch_vccnz L_gi
    s_waitcnt vmcnt(33)
    s_add_u32 s46, s45, 24576
    s_and_b32 s46, s46, 0x7fff
    s_add_u32 m0, s46, 54016
    s_add_u32 s41, s38, s46
    buffer_load_dwordx4 v13, s[16:19], s41 offen offset:0 nt lds
    s_waitcnt vmcnt(33)
    buffer_load_dwordx4 v14, s[16:19], s41 offen offset:1024 nt lds
    s_waitcnt vmcnt(33)
    buffer_load_dwordx4 v13, s[16:19], s41 offen offset:2048 nt lds
    s_waitcnt vmcnt(33)
    buffer_load_dwordx4 v14, s[16:19], s41 offen offset:3072 nt lds
    s_waitcnt vmcnt(33)
    s_add_u32 s46, s45, 28672
    s_and_b32 s46, s46, 0x7fff
    s_add_u32 m0, s46, 54016
    s_add_u32 s41, s38, s46
    buffer_load_dwordx4 v13, s[16:19], s41 offen offset:0 nt lds
    s_waitcnt vmcnt(33)
    buffer_load_dwordx4 v14, s[16:19], s41 offen offset:1024 nt lds
    s_waitcnt vmcnt(33)
    buffer_load_dwordx4 v13, s[16:19], s41 offen offset:2048 nt lds
    s_waitcnt vmcnt(33)
    buffer_load_dwordx4 v14, s[16:19], s41 offen offset:3072 nt lds
    s_waitcnt vmcnt(33)
    s_mov_b32 m0, 86784
    s_nop 0
    buffer_load_dwordx4 v15, s[24:27], s42 offen offset:0 nt lds
    s_waitcnt vmcnt(33)
    s_add_u32 s42, s42, 3072
    buffer_load_dwordx4 v15, s[24:27], s42 offen offset:1024 nt lds
    s_waitcnt vmcnt(33)
    s_add_u32 s42, s42, 3072
    buffer_load_dwordx4 v16, s[24:27], s42 offen offset:2048 nt lds
    s_waitcnt vmcnt(33)
    s_add_u32 s42, s42, 3072
    buffer_load_dwordx4 v16, s[24:27], s42 offen offset:3072 nt lds
    s_waitcnt vmcnt(33)
    s_add_u32 m0, m0, 4096
    s_add_u32 s42, s42, 7168
    buffer_load_dwordx4 v15, s[24:27], s42 offen offset:0 nt lds
    s_waitcnt vmcnt(33)
    s_add_u32 s42, s42, 3072
    buffer_load_dwordx4 v15, s[24:27], s42 offen offset:1024 nt lds
    s_waitcnt vmcnt(33)
    s_add_u32 s42, s42, 3072
    buffer_load_dwordx4 v16, s[24:27], s42 offen offset:2048 nt lds
    s_waitcnt vmcnt(33)
    s_add_u32 s42, s42, 3072
    buffer_load_dwordx4 v16, s[24:27], s42 offen offset:3072 nt lds
    s_waitcnt vmcnt(33)
    s_add_u32 m0, m0, 4096
    s_add_u32 s42, s42, 7168
    buffer_load_dwordx4 v15, s[24:27], s42 offen offset:0 nt lds
    s_waitcnt vmcnt(33)
    s_add_u32 s42, s42, 3072
    buffer_load_dwordx4 v15, s[24:27], s42 offen offset:1024 nt lds
    s_waitcnt vmcnt(33)
    s_add_u32 s42, s42, 3072
    buffer_load_dwordx4 v16, s[24:27], s42 offen offset:2048 nt lds
    s_waitcnt vmcnt(33)
    s_add_u32 s42, s42, 3072
    buffer_load_dwordx4 v16, s[24:27], s42 offen offset:3072 nt lds
    s_waitcnt vmcnt(33)
    s_add_u32 m0, m0, 4096
    s_add_u32 s42, s42, 7168
    buffer_load_dwordx4 v15, s[24:27], s42 offen offset:0 nt lds
    s_waitcnt vmcnt(33)
    s_add_u32 s42, s42, 3072
    buffer_load_dwordx4 v15, s[24:27], s42 offen offset:1024 nt lds
    s_waitcnt vmcnt(33)
    s_add_u32 s42, s42, 3072
    buffer_load_dwordx4 v16, s[24:27], s42 offen offset:2048 nt lds
    s_waitcnt vmcnt(33)
    s_add_u32 s42, s42, 3072
    buffer_load_dwordx4 v16, s[24:27], s42 offen offset:3072 nt lds
    s_waitcnt vmcnt(16)
    ds_write_b32 v17, v18 offset:136
    s_waitcnt vmcnt(0)
    ds_write_b32 v17, v18 offset:140
    s_endpgm
L_compute:
    s_mov_b32 s31, s23
    s_mov_b32 s30, 268435456
    s_mov_b32 s35, s23
    s_movk_i32 s34, 0x1000
    s_lshl_b32 s39, s4, 4
    s_add_u32 s39, s39, s6
    s_lshl_b32 s39, s39, 11
    s_xor_b32 s36, s7, 0
    s_lshl_b32 s36, s36, 8
    s_add_u32 s39, s39, s36
    s_add_u32 s39, s39, 260112384
    s_lshl_b32 s40, s6, 3
    s_add_u32 s40, s40, s4
    s_lshl_b32 s40, s40, 5
    s_add_u32 s40, s40, s7
    s_lshl_b32 s40, s40, 9
    s_add_u32 s40, s40, 260571136
    s_mov_b32 s36, 260046848
    s_waitcnt lgkmcnt(0)
    s_load_dword s41, s[28:29], s36
    s_lshl_b32 s36, s3, 13
    s_add_u32 s44, s39, s36
    s_lshl_b32 s36, s3, 12
    s_add_u32 s45, s40, s36
    v_lshrrev_b32 v6, 4, v1
    v_and_b32 v7, 15, v1
    v_and_b32 v8, 3, v1
    v_lshlrev_b32 v4, 2, v1
    v_mov_b32 v5, 0
    ds_write_b32 v4, v5 offset:3136
    v_add_u32 v4, 3296, v4
    s_lshl_b32 s36, s3, 2
    s_add_u32 s36, s36, 3136
    v_mov_b32 v39, s36
    v_cmp_eq_u32 vcc, 0, v1
    v_mov_b32 v40, 3136
    v_mov_b32 v41, 1
    v_cndmask_b32 v39, v4, v39, vcc
    s_lshr_b32 s48, s5, 2
    s_lshl_b32 s46, s4, 3
    s_add_u32 s46, s46, s48
    s_and_b32 s47, s5, 3
    v_lshlrev_b32 v4, 2, v8
    v_xor_b32 v4, v6, v4
    v_lshlrev_b32 v4, 4, v4
    v_lshl_add_u32 v4, v8, 8, v4
    v_add_u32 v11, 3840, v4
    v_xor_b32 v12, 64, v11
    v_xor_b32 v13, 0x80, v11
    v_xor_b32 v14, 0xc0, v11
    v_bfe_u32 v2, v1, 2, 2
    v_lshl_add_u32 v4, v6, 3, v2
    v_lshlrev_b32 v4, 7, v4
    v_lshl_add_u32 v4, v8, 3, v4
    v_lshrrev_b32 v5, 1, v2
    v_and_b32 v3, 1, v6
    v_lshl_or_b32 v5, v3, 1, v5
    v_xor_b32 v5, s3, v5
    v_lshl_add_u32 v4, v5, 5, v4
    v_add_u32 v15, 4864, v4
    s_lshl_b32 s36, s3, 13
    s_add_u32 s36, s36, 21248
    v_xor_b32 v4, v6, v7
    v_lshlrev_b32 v4, 4, v4
    v_lshl_add_u32 v4, v7, 8, v4
    v_add_u32 v16, s36, v4
    v_xor_b32 v17, 64, v16
    v_xor_b32 v18, 0x80, v16
    v_xor_b32 v19, 0xc0, v16
    v_lshl_add_u32 v4, v6, 2, v2
    v_lshlrev_b32 v4, 8, v4
    v_lshl_add_u32 v4, v8, 3, v4
    v_lshl_or_b32 v5, v3, 2, v2
    s_lshl_b32 s36, s3, 1
    v_xor_b32 v5, s36, v5
    v_lshl_add_u32 v4, v5, 5, v4
    v_add_u32 v20, 54016, v4
    v_xor_b32 v21, 32, v20
    v_lshl_add_u32 v4, v6, 3, v2
    v_lshlrev_b32 v4, 8, v4
    v_lshl_add_u32 v4, v8, 3, v4
    v_lshl_add_u32 v4, v5, 5, v4
    v_add_u32 v22, 86784, v4
    v_xor_b32 v23, 32, v22
    v_cmp_gt_u32 vcc, 4, v7
    v_mov_b32 v5, 0x7ffffff0
    s_lshl_b32 s36, s3, 6
    v_lshlrev_b32 v4, 4, v6
    v_add_u32 v2, s36, v4
    v_lshl_add_u32 v2, v7, 13, v2
    v_cndmask_b32 v24, v5, v2, vcc
    s_lshl_b32 s36, s3, 7
    v_add_u32 v4, s36, v4
    v_lshl_add_u32 v2, v7, 12, v4
    v_cndmask_b32 v32, v5, v2, vcc
    v_lshl_add_u32 v2, v7, 9, v4
    v_cndmask_b32 v36, v5, v2, vcc
    s_lshl_b32 s36, s3, 9
    v_lshlrev_b32 v2, 4, v1
    v_add_u32 v2, s36, v2
    v_cmp_gt_u32 s[60:61], 32, v1
    v_cmp_eq_u32 s[62:63], 1, v6
    s_nop 0
    v_cndmask_b32 v36, v5, v2, s[60:61]
    v_lshrrev_b32 v2, 5, v1
    v_and_b32 v3, 31, v1
    v_lshlrev_b32 v4, 4, v3
    v_lshl_add_u32 v25, v2, 12, v4
    s_lshl_b32 s49, s4, 2
    s_add_u32 s49, s49, s6
    s_lshl_b32 s49, s49, 4
    s_add_u32 s49, s49, s3
    s_lshl_b32 s49, s49, 9
    s_add_u32 s49, s49, 260112384
    s_mul_i32 s36, s3, 320
    v_lshlrev_b32 v4, 3, v3
    v_lshl_add_u32 v4, v2, 2, v4
    v_add_u32 v26, s36, v4
    v_mul_u32_u24 v4, 320, v8
    v_lshl_add_u32 v27, v6, 4, v4
    v_lshlrev_b32 v4, 6, v8
    v_lshl_add_u32 v29, v6, 4, v4
    s_lshl_b32 s36, s3, 8
    v_add_u32 v28, s36, v29
    v_lshlrev_b32 v31, 4, v8
    s_lshl_b32 s36, s3, 2
    v_add_u32 v30, s36, v31
    v_lshlrev_b32 v4, 9, v6
    v_lshl_add_u32 v33, v7, 4, v4
    s_lshl_b32 s50, s3, 3
    s_add_u32 s50, s50, s4
    s_lshl_b32 s50, s50, 2
    s_add_u32 s50, s50, s6
    s_lshl_b32 s50, s50, 4
    s_and_b32 s36, s48, 1
    s_add_u32 s50, s50, s36
    s_lshl_b32 s50, s50, 8
    s_add_u32 s50, s50, 260571136
    s_mul_i32 s36, s3, 192
    v_lshlrev_b32 v4, 3, v7
    v_lshl_add_u32 v4, v6, 1, v4
    v_add_u32 v34, s36, v4
    v_mul_u32_u24 v4, 192, v8
    v_lshl_add_u32 v35, v6, 4, v4
    s_lshl_b32 s51, s47, 6
    s_add_u32 s51, s51, s46
    s_lshl_b32 s51, s51, 11
    s_add_u32 s51, s51, 263192576
    v_lshrrev_b32 v2, 1, v1
    v_and_b32 v3, 1, v1
    v_lshlrev_b32 v4, 4, v3
    v_lshl_add_u32 v37, v2, 11, v4
    s_lshl_b32 s52, s47, 12
    s_add_u32 s52, s52, s46
    s_lshl_b32 s52, s52, 5
    s_add_u32 s52, s52, 263192576
    s_lshl_b32 s36, s47, 6
    s_add_u32 s36, s36, s46
    s_lshl_b32 s36, s36, 2
    v_lshlrev_b32 v4, 1, v3
    v_lshl_add_u32 v4, v6, 10, v4
    v_add_u32 v4, s36, v4
    v_cmp_gt_u32 vcc, 2, v7
    s_mov_b32 s53, 0x3e0293ee
    s_mov_b32 s54, 0x07060503
    v_cndmask_b32 v38, v5, v4, vcc
    s_mov_b32 s55, 0x07060502
    s_mov_b32 s56, 0x07060501
    s_mov_b32 s57, 0x04000c0c
    s_mov_b32 s58, 0x0706000c
    s_mov_b32 s60, 0x000f000f
    s_mov_b32 s61, 0x000f000f
    s_waitcnt lgkmcnt(0)
    s_mul_i32 s42, s41, 1664525
    s_add_u32 s42, s42, 1013904223
    v_mov_b32 v140, 0x3f803f80
    v_mov_b32 v141, 0x3f803f80
    v_mov_b32 v142, 0x3f803f80
    v_mov_b32 v143, 0x3f803f80
    v_mov_b32 v155, s42
    v_mov_b32 v159, s42
    v_mov_b32 v163, s42
    v_mov_b32 v127, s42
    v_mov_b32 v131, s42
    s_add_u32 s65, s39, 2097152
    s_add_u32 s66, s40, 2097152
    s_mov_b32 s64, 100000
    s_movk_i32 s67, 2000
    s_waitcnt lgkmcnt(0)
    s_barrier
    ds_read_b128 v[44:47], v11
    ds_read_b64_tr_b16 v[60:61], v15 offset:0
    ds_read_b64_tr_b16 v[62:63], v15 offset:512
    ds_read_b128 v[48:51], v12
    ds_read_b64_tr_b16 v[64:65], v15 offset:4096
    ds_read_b64_tr_b16 v[66:67], v15 offset:4608
    ds_read_b128 v[52:55], v13
    ds_read_b64_tr_b16 v[68:69], v15 offset:8192
    ds_read_b64_tr_b16 v[70:71], v15 offset:8704
    ds_read_b128 v[56:59], v14
    ds_read_b64_tr_b16 v[72:73], v15 offset:12288
    ds_read_b64_tr_b16 v[74:75], v15 offset:12800
    s_waitcnt lgkmcnt(9)
    v_mfma_f32_16x16x32_bf16 v[92:95], v[60:63], v[44:47], 0
    s_waitcnt lgkmcnt(6)
    v_mfma_f32_16x16x32_bf16 v[92:95], v[64:67], v[48:51], v[92:95]
    s_waitcnt lgkmcnt(3)
    v_mfma_f32_16x16x32_bf16 v[92:95], v[68:71], v[52:55], v[92:95]
    s_waitcnt lgkmcnt(0)
    v_mfma_f32_16x16x32_bf16 v[92:95], v[72:75], v[56:59], v[92:95]
    s_nop 7
    v_perm_b32 v152, v92, v95, s54
    v_perm_b32 v153, v93, v95, s55
    v_perm_b32 v154, v94, v95, s56
    buffer_store_dwordx4 v[152:155], v24, s[28:31], s39 offen
    ds_write_b32 v39, v41 offset:64
    s_load_dword s43, s[28:29], s44 offset:0
    s_load_dword s43, s[28:29], s44 offset:64
    s_load_dword s43, s[28:29], s44 offset:128
    s_load_dword s43, s[28:29], s44 offset:192
    s_load_dword s43, s[28:29], s45 offset:0
    s_load_dword s43, s[28:29], s45 offset:64
    s_load_dword s43, s[28:29], s45 offset:128
    s_load_dword s43, s[28:29], s45 offset:192
    s_load_dword s43, s[28:29], s45 offset:256
    s_load_dword s43, s[28:29], s45 offset:320
    s_load_dword s43, s[28:29], s45 offset:384
    s_load_dword s43, s[28:29], s45 offset:448
    s_mov_b64 exec, 0
    s_cmp_eq_u32 s3, 1
    s_cbranch_scc1 HOPB_P1
    s_cmp_eq_u32 s3, 2
    s_cbranch_scc1 HOPB_P2
    s_cmp_eq_u32 s3, 3
    s_cbranch_scc1 HOPB_P3
    s_branch HOPB_P0
L_warm_doneB:
    s_mov_b64 exec, -1
L_wf1:
    ds_read_b32 v148, v40 offset:128
    s_waitcnt lgkmcnt(0)
    v_cmp_eq_u32 vcc, 0, v148
    s_cbranch_vccz L_wf1d
    s_sub_u32 s67, s67, 1
    s_cbranch_scc0 L_wf1
    s_branch L_wf1f
L_wf1d:
    buffer_load_dwordx4 v[132:135], v25, s[28:31], s49 offen sc1
    buffer_load_dwordx4 v[136:139], v25, s[28:31], s49 offen offset:2048 sc1
    ds_write_b32 v39, v41 offset:48
    ds_read_b128 v[44:47], v16 offset:0
    ds_read_b128 v[48:51], v17 offset:0
    ds_read_b128 v[52:55], v18 offset:0
    ds_read_b128 v[56:59], v19 offset:0
    ds_read_b128 v[60:63], v16 offset:4096
    ds_read_b128 v[64:67], v17 offset:4096
    ds_read_b128 v[68:71], v18 offset:4096
    ds_read_b128 v[72:75], v19 offset:4096
    s_waitcnt vmcnt(0)
L_qchk:
    v_cmp_ne_u32 vcc, s42, v135
HOPB_P0:
L_hB_0:
    s_cbranch_execz L_hB_1
    v_cmp_ne_u32 s[68:69], s42, v139
    s_or_b64 vcc, vcc, s[68:69]
    s_cbranch_vccnz L_qretry
L_qok:
    v_perm_b32 v124, v132, v133, s57
    v_perm_b32 v125, v136, v137, s57
    v_add_f32 v128, v132, v136
    v_add_f32 v130, v134, v138
    v_perm_b32 v124, v124, v134, s58
    v_perm_b32 v125, v125, v138, s58
    v_add_f32 v129, v133, v137
    v_add_f32 v131, v124, v125
    v_permlane32_swap_b32 v128, v130
    s_nop 0
    v_permlane32_swap_b32 v129, v131
    v_add_f32 v128, v128, v130
    v_add_f32 v129, v129, v131
    v_cvt_pk_bf16_f32 v124, v128, v129
    ds_write_b32 v26, v124 offset:0
    ds_write_b32 v39, v41 offset:0
L_wf2:
    ds_read_b128 v[144:147], v40 offset:0
    s_waitcnt lgkmcnt(0)
    v_min3_u32 v144, v144, v145, v146
L_hB_1:
    s_cbranch_execz L_hB_2
    v_min_u32 v144, v144, v147
    v_cmp_eq_u32 vcc, 0, v144
    s_cbranch_vccz L_wf2d
    s_sub_u32 s67, s67, 1
    s_cbranch_scc0 L_wf2
    s_branch L_wf2f
L_wf2d:
    ds_read_b128 v[76:79], v27 offset:0
    ds_read_b128 v[80:83], v27 offset:64
    ds_read_b128 v[84:87], v27 offset:128
    ds_read_b128 v[88:91], v27 offset:192
    s_waitcnt lgkmcnt(3)
    v_mfma_f32_16x16x32_bf16 v[92:95], v[44:47], v[76:79], 0
    v_mfma_f32_16x16x32_bf16 v[96:99], v[60:63], v[76:79], 0
    s_waitcnt lgkmcnt(2)
    v_mfma_f32_16x16x32_bf16 v[92:95], v[48:51], v[80:83], v[92:95]
    v_mfma_f32_16x16x32_bf16 v[96:99], v[64:67], v[80:83], v[96:99]
    s_waitcnt lgkmcnt(1)
    v_mfma_f32_16x16x32_bf16 v[92:95], v[52:55], v[84:87], v[92:95]
    v_mfma_f32_16x16x32_bf16 v[96:99], v[68:71], v[84:87], v[96:99]
    s_waitcnt lgkmcnt(0)
L_hB_2:
    s_cbranch_execz L_hB_3
    v_mfma_f32_16x16x32_bf16 v[92:95], v[56:59], v[88:91], v[92:95]
    v_mfma_f32_16x16x32_bf16 v[96:99], v[72:75], v[88:91], v[96:99]
    s_mov_b32 s70, s53
    s_mov_b32 s71, s53
    s_nop 4
    v_max3_f32 v164, v92, v93, v94
    v_max3_f32 v166, v95, v96, v97
    v_max3_f32 v164, v164, v98, v99
    v_max_f32 v164, v164, v166
    v_mov_b32 v166, v164
    s_nop 1
    v_permlane16_swap_b32 v164, v166
    v_max_f32 v164, v164, v166
    v_mov_b32 v166, v164
    s_nop 1
    v_permlane32_swap_b32 v164, v166
    v_max_f32 v164, v164, v166
    v_mul_f32 v164, s53, v164
    v_pk_fma_f32 v[92:93], v[92:93], s[70:71], v[164:165] op_sel_hi:[1,1,0] neg_lo:[0,0,1] neg_hi:[0,0,1]
    v_pk_fma_f32 v[94:95], v[94:95], s[70:71], v[164:165] op_sel_hi:[1,1,0] neg_lo:[0,0,1] neg_hi:[0,0,1]
    v_pk_fma_f32 v[96:97], v[96:97], s[70:71], v[164:165] op_sel_hi:[1,1,0] neg_lo:[0,0,1] neg_hi:[0,0,1]
    v_pk_fma_f32 v[98:99], v[98:99], s[70:71], v[164:165] op_sel_hi:[1,1,0] neg_lo:[0,0,1] neg_hi:[0,0,1]
L_hB_3:
    s_cbranch_execz L_hB_4
    s_mov_b64 exec, s[60:61]
    ds_write_b32 v30, v164 offset:2304
    s_mov_b64 exec, -1
    v_exp_f32 v92, v92
    v_exp_f32 v93, v93
    v_exp_f32 v94, v94
    v_cvt_pk_bf16_f32 v124, v92, v93
    v_exp_f32 v95, v95
    v_exp_f32 v96, v96
    v_cvt_pk_bf16_f32 v125, v94, v95
    v_exp_f32 v97, v97
    v_exp_f32 v98, v98
    v_cvt_pk_bf16_f32 v126, v96, v97
    v_exp_f32 v99, v99
    s_mov_b64 exec, s[60:61]
    v_cvt_pk_bf16_f32 v127, v98, v99
    ds_write_b128 v28, v[124:127] offset:1280
    s_mov_b64 exec, -1
    ds_write_b32 v39, v41 offset:16
    s_mov_b32 s64, 100000
L_wf3:
    ds_read_b128 v[144:147], v40 offset:16
    s_waitcnt lgkmcnt(0)
L_hB_4:
    s_cbranch_execz L_warm_doneB
    v_min3_u32 v144, v144, v145, v146
    v_min_u32 v144, v144, v147
    v_cmp_eq_u32 vcc, 0, v144
    s_cbranch_vccz L_wf3d
    s_sub_u32 s67, s67, 1
    s_cbranch_scc0 L_wf3
    s_branch L_wf3f
L_wf3d:
    ds_read_b128 v[132:135], v31 offset:2304
    ds_read_b128 v[76:79], v29 offset:1280
    ds_read_b128 v[80:83], v29 offset:1536
    ds_read_b128 v[84:87], v29 offset:1792
    ds_read_b128 v[88:91], v29 offset:2048
    ds_read_b32 v148, v40 offset:136
    s_waitcnt lgkmcnt(5)
    v_max3_f32 v184, v132, v133, v134
    v_max_f32 v184, v184, v135
    v_sub_f32 v186, v132, v184
    v_sub_f32 v187, v133, v184
    v_sub_f32 v188, v134, v184
    v_sub_f32 v189, v135, v184
    s_waitcnt lgkmcnt(4)
    v_mfma_f32_16x16x32_bf16 v[168:171], v[140:143], v[76:79], 0
HOPB_P1:
L_hB_5:
    s_cbranch_execz L_hB_6
    v_exp_f32 v186, v186
    s_waitcnt lgkmcnt(3)
    v_mfma_f32_16x16x32_bf16 v[172:175], v[140:143], v[80:83], 0
    v_exp_f32 v187, v187
    s_waitcnt lgkmcnt(2)
    v_mfma_f32_16x16x32_bf16 v[176:179], v[140:143], v[84:87], 0
    v_exp_f32 v188, v188
    s_waitcnt lgkmcnt(1)
    v_mfma_f32_16x16x32_bf16 v[180:183], v[140:143], v[88:91], 0
    v_exp_f32 v189, v189
    s_waitcnt lgkmcnt(0)
    v_cmp_ne_u32 vcc, 0, v148
    s_cbranch_vccnz L_vfast
    s_nop 3
    v_mul_f32 v190, v186, v168
    v_fmac_f32 v190, v187, v172
    v_fmac_f32 v190, v188, v176
    v_fmac_f32 v190, v189, v180
    v_rcp_f32 v191, v190
    v_log_f32 v192, v190
    s_nop 0
    v_mul_f32 v186, v186, v191
    v_mul_f32 v187, v187, v191
    v_mul_f32 v188, v188, v191
    v_mul_f32 v189, v189, v191
    v_add_f32 v158, v192, v184
    v_add_f32 v162, v192, v184
L_wf4:
    ds_read_b32 v148, v40 offset:136
L_hB_6:
    s_cbranch_execz L_hB_7
    s_waitcnt lgkmcnt(0)
    v_cmp_eq_u32 vcc, 0, v148
    s_cbranch_vccz L_wf4d
    s_sub_u32 s67, s67, 1
    s_cbranch_scc0 L_wf4
    s_branch L_wf4f
L_wf4d:
    ds_read_b64_tr_b16 v[44:45], v20 offset:0
    ds_read_b64_tr_b16 v[46:47], v20 offset:4096
    ds_read_b64_tr_b16 v[48:49], v21 offset:0
    ds_read_b64_tr_b16 v[50:51], v21 offset:4096
    ds_read_b64_tr_b16 v[52:53], v20 offset:8192
    ds_read_b64_tr_b16 v[54:55], v20 offset:12288
    ds_read_b64_tr_b16 v[56:57], v21 offset:8192
    ds_read_b64_tr_b16 v[58:59], v21 offset:12288
    ds_read_b64_tr_b16 v[60:61], v20 offset:16384
    ds_read_b64_tr_b16 v[62:63], v20 offset:20480
    ds_read_b64_tr_b16 v[64:65], v21 offset:16384
    ds_read_b64_tr_b16 v[66:67], v21 offset:20480
L_hB_7:
    s_cbranch_execz L_hB_8
    s_branch L_vjoin
L_vfast:
    ds_read_b64_tr_b16 v[44:45], v20 offset:0
    ds_read_b64_tr_b16 v[46:47], v20 offset:4096
    ds_read_b64_tr_b16 v[48:49], v21 offset:0
    ds_read_b64_tr_b16 v[50:51], v21 offset:4096
    ds_read_b64_tr_b16 v[52:53], v20 offset:8192
    ds_read_b64_tr_b16 v[54:55], v20 offset:12288
    ds_read_b64_tr_b16 v[56:57], v21 offset:8192
    ds_read_b64_tr_b16 v[58:59], v21 offset:12288
    ds_read_b64_tr_b16 v[60:61], v20 offset:16384
    ds_read_b64_tr_b16 v[62:63], v20 offset:20480
    ds_read_b64_tr_b16 v[64:65], v21 offset:16384
    ds_read_b64_tr_b16 v[66:67], v21 offset:20480
    v_mul_f32 v190, v186, v168
    v_fmac_f32 v190, v187, v172
    v_fmac_f32 v190, v188, v176
    v_fmac_f32 v190, v189, v180
    v_rcp_f32 v191, v190
    v_log_f32 v192, v190
L_hB_8:
    s_cbranch_execz L_hB_9
    s_nop 0
    v_mul_f32 v186, v186, v191
    v_mul_f32 v187, v187, v191
    v_mul_f32 v188, v188, v191
    v_mul_f32 v189, v189, v191
    v_add_f32 v158, v192, v184
    v_add_f32 v162, v192, v184
L_vjoin:
    s_waitcnt lgkmcnt(8)
    v_mfma_f32_16x16x32_bf16 v[92:95], v[44:47], v[76:79], 0
    v_mfma_f32_16x16x32_bf16 v[96:99], v[48:51], v[76:79], 0
    ds_read_b64_tr_b16 v[68:69], v20 offset:24576
    ds_read_b64_tr_b16 v[70:71], v20 offset:28672
    ds_read_b64_tr_b16 v[72:73], v21 offset:24576
    ds_read_b64_tr_b16 v[74:75], v21 offset:28672
    s_waitcnt lgkmcnt(8)
    v_mfma_f32_16x16x32_bf16 v[100:103], v[52:55], v[80:83], 0
    v_mfma_f32_16x16x32_bf16 v[104:107], v[56:59], v[80:83], 0
    s_waitcnt lgkmcnt(4)
    v_mfma_f32_16x16x32_bf16 v[108:111], v[60:63], v[84:87], 0
    v_mfma_f32_16x16x32_bf16 v[112:115], v[64:67], v[84:87], 0
    s_waitcnt lgkmcnt(0)
L_hB_9:
    s_cbranch_execz L_warm_doneB
    v_mfma_f32_16x16x32_bf16 v[116:119], v[68:71], v[88:91], 0
    v_mfma_f32_16x16x32_bf16 v[120:123], v[72:75], v[88:91], 0
    v_pk_mul_f32 v[132:133], v[92:93], v[186:187] op_sel:[0,0] op_sel_hi:[1,0]
    v_pk_mul_f32 v[134:135], v[94:95], v[186:187] op_sel:[0,0] op_sel_hi:[1,0]
    v_pk_mul_f32 v[136:137], v[96:97], v[186:187] op_sel:[0,0] op_sel_hi:[1,0]
    v_pk_mul_f32 v[138:139], v[98:99], v[186:187] op_sel:[0,0] op_sel_hi:[1,0]
    v_pk_fma_f32 v[132:133], v[100:101], v[186:187], v[132:133] op_sel:[0,1,0] op_sel_hi:[1,1,1]
    v_pk_fma_f32 v[134:135], v[102:103], v[186:187], v[134:135] op_sel:[0,1,0] op_sel_hi:[1,1,1]
    v_pk_fma_f32 v[136:137], v[104:105], v[186:187], v[136:137] op_sel:[0,1,0] op_sel_hi:[1,1,1]
    v_pk_fma_f32 v[138:139], v[106:107], v[186:187], v[138:139] op_sel:[0,1,0] op_sel_hi:[1,1,1]
    v_pk_fma_f32 v[132:133], v[108:109], v[188:189], v[132:133] op_sel:[0,0,0] op_sel_hi:[1,0,1]
    v_pk_fma_f32 v[134:135], v[110:111], v[188:189], v[134:135] op_sel:[0,0,0] op_sel_hi:[1,0,1]
    v_pk_fma_f32 v[136:137], v[112:113], v[188:189], v[136:137] op_sel:[0,0,0] op_sel_hi:[1,0,1]
    v_pk_fma_f32 v[138:139], v[114:115], v[188:189], v[138:139] op_sel:[0,0,0] op_sel_hi:[1,0,1]
    v_pk_fma_f32 v[132:133], v[116:117], v[188:189], v[132:133] op_sel:[0,1,0] op_sel_hi:[1,1,1]
    v_pk_fma_f32 v[134:135], v[118:119], v[188:189], v[134:135] op_sel:[0,1,0] op_sel_hi:[1,1,1]
HOPB_P2:
L_hB_10:
    s_cbranch_execz L_hB_11
    v_pk_fma_f32 v[136:137], v[120:121], v[188:189], v[136:137] op_sel:[0,1,0] op_sel_hi:[1,1,1]
    v_pk_fma_f32 v[138:139], v[122:123], v[188:189], v[138:139] op_sel:[0,1,0] op_sel_hi:[1,1,1]
L_vdone:
    v_cvt_pk_bf16_f32 v156, v132, v133
    v_cvt_pk_bf16_f32 v157, v134, v135
    v_cvt_pk_bf16_f32 v160, v136, v137
    v_cvt_pk_bf16_f32 v161, v138, v139
    buffer_store_dwordx4 v[156:159], v32, s[28:31], s40 offen
    buffer_store_dwordx4 v[160:163], v32, s[28:31], s40 offen offset:64
    ds_write_b32 v39, v41 offset:96
L_wf5:
    ds_read_b128 v[144:147], v40 offset:96
    s_waitcnt lgkmcnt(0)
    v_min3_u32 v144, v144, v145, v146
    v_min_u32 v144, v144, v147
    v_cmp_eq_u32 vcc, 0, v144
    s_cbranch_vccz L_wf5d
    s_sub_u32 s67, s67, 1
    s_cbranch_scc0 L_wf5
    s_branch L_wf5f
L_wf5d:
    buffer_load_dwordx4 v[76:79], v33, s[28:31], s50 offen sc1
L_hB_11:
    s_cbranch_execz L_hB_12
    buffer_load_dwordx4 v[80:83], v33, s[28:31], s50 offen offset:2048 sc1
L_wf6:
    ds_read_b32 v148, v40 offset:140
    s_waitcnt lgkmcnt(0)
    v_cmp_eq_u32 vcc, 0, v148
    s_cbranch_vccz L_wf6d
    s_sub_u32 s67, s67, 1
    s_cbranch_scc0 L_wf6
    s_branch L_wf6f
L_wf6d:
    ds_read_b64_tr_b16 v[44:45], v22 offset:0
    ds_read_b64_tr_b16 v[46:47], v22 offset:1024
    ds_read_b64_tr_b16 v[48:49], v23 offset:0
    ds_read_b64_tr_b16 v[50:51], v23 offset:1024
    ds_read_b64_tr_b16 v[52:53], v22 offset:8192
    ds_read_b64_tr_b16 v[54:55], v22 offset:9216
    ds_read_b64_tr_b16 v[56:57], v23 offset:8192
    ds_read_b64_tr_b16 v[58:59], v23 offset:9216
    s_waitcnt vmcnt(0)
L_ochk:
    v_cmp_ne_u32 vcc, s42, v79
    v_cmp_ne_u32 s[68:69], s42, v83
L_hB_12:
    s_cbranch_execz L_hB_13
    s_or_b64 vcc, vcc, s[68:69]
    s_cbranch_vccnz L_oretry
L_ook:
    v_max_f32 v184, v78, v82
    v_mov_b32 v166, v184
    v_lshlrev_b32 v60, 16, v76
    v_and_b32 v61, 0xffff0000, v76
    v_permlane16_swap_b32 v184, v166
    v_lshlrev_b32 v62, 16, v77
    v_max_f32 v184, v184, v166
    v_mov_b32 v166, v184
    v_and_b32 v63, 0xffff0000, v77
    v_lshlrev_b32 v64, 16, v80
    v_permlane32_swap_b32 v184, v166
    v_and_b32 v65, 0xffff0000, v80
    v_max_f32 v184, v184, v166
    v_lshlrev_b32 v66, 16, v81
    v_sub_f32 v193, v78, v184
    v_sub_f32 v194, v82, v184
    v_exp_f32 v193, v193
    v_exp_f32 v194, v194
    v_and_b32 v67, 0xffff0000, v81
    v_add_f32 v195, v193, v194
    v_mul_f32 v68, v193, v60
    v_mul_f32 v69, v193, v61
    v_mov_b32 v166, v195
    v_mul_f32 v70, v193, v62
    v_mul_f32 v71, v193, v63
L_hB_13:
    s_cbranch_execz L_hB_14
    v_permlane16_swap_b32 v195, v166
    v_fmac_f32 v68, v194, v64
    v_fmac_f32 v69, v194, v65
    v_add_f32 v195, v195, v166
    v_fmac_f32 v70, v194, v66
    v_fmac_f32 v71, v194, v67
    v_mov_b32 v166, v195
    v_permlane16_swap_b32 v68, v69
    s_nop 0
    v_permlane16_swap_b32 v70, v71
    v_permlane32_swap_b32 v195, v166
    v_add_f32 v68, v68, v69
    v_add_f32 v70, v70, v71
    v_add_f32 v195, v195, v166
    s_nop 0
    v_permlane32_swap_b32 v68, v70
    v_rcp_f32 v195, v195
    v_add_f32 v68, v68, v70
    v_mul_f32 v68, v68, v195
    v_cvt_pk_bf16_f32 v68, v68, v68
    ds_write_b16 v34, v68 offset:2368
    ds_write_b32 v39, v41 offset:32
    s_add_u32 s37, s52, 65536
    s_mov_b32 s64, 100000
L_wf7:
    ds_read_b128 v[144:147], v40 offset:32
L_hB_14:
    s_cbranch_execz L_warm_doneB
    s_waitcnt lgkmcnt(0)
    v_min3_u32 v144, v144, v145, v146
    v_min_u32 v144, v144, v147
    v_cmp_eq_u32 vcc, 0, v144
    s_cbranch_vccz L_wf7d
    s_sub_u32 s67, s67, 1
    s_cbranch_scc0 L_wf7
    s_branch L_wf7f
L_wf7d:
    ds_read_b128 v[84:87], v35 offset:2368
    ds_read_b128 v[88:91], v35 offset:2432
    s_waitcnt lgkmcnt(1)
    v_mfma_f32_16x16x32_bf16 v[92:95], v[84:87], v[44:47], 0
    v_mfma_f32_16x16x32_bf16 v[96:99], v[84:87], v[48:51], 0
    s_waitcnt lgkmcnt(0)
    v_mfma_f32_16x16x32_bf16 v[92:95], v[88:91], v[52:55], v[92:95]
    v_mfma_f32_16x16x32_bf16 v[96:99], v[88:91], v[56:59], v[96:99]
    v_mov_b32 v127, s42
    s_nop 6
    v_cndmask_b32 v92, v92, v96, s[62:63]
    v_cndmask_b32 v93, v93, v97, s[62:63]
    v_cndmask_b32 v94, v94, v98, s[62:63]
HOPB_P3:
L_hB_15:
    s_cbranch_execz L_hB_16
    v_cndmask_b32 v95, v95, v99, s[62:63]
    v_perm_b32 v124, v92, v95, s54
    v_perm_b32 v125, v93, v95, s55
    v_perm_b32 v126, v94, v95, s56
    buffer_store_dwordx4 v[124:127], v36, s[28:31], s51 offen sc1
    ds_write_b32 v39, v41 offset:112
L_wf8:
    ds_read_b128 v[144:147], v40 offset:112
    s_waitcnt lgkmcnt(0)
    v_min3_u32 v144, v144, v145, v146
    v_min_u32 v144, v144, v147
    v_cmp_eq_u32 vcc, 0, v144
    s_cbranch_vccz L_wf8d
    s_sub_u32 s67, s67, 1
    s_cbranch_scc0 L_wf8
    s_branch L_wf8f
L_wf8d:
    buffer_store_dwordx4 v[152:155], v24, s[28:31], s65 offen sc1
    buffer_store_dwordx4 v[156:159], v32, s[28:31], s66 offen sc1
    buffer_store_dwordx4 v[160:163], v32, s[28:31], s66 offen offset:64 sc1
    s_cmp_lg_u32 s3, 0
    s_cbranch_scc1 L_fin
L_fpoll:
L_hB_16:
    s_cbranch_execz L_hB_17
    buffer_load_dwordx4 v[108:111], v37, s[28:31], s52 offen sc1
    buffer_load_dwordx4 v[112:115], v37, s[28:31], s37 offen sc1
    s_waitcnt vmcnt(0)
    v_cmp_ne_u32 vcc, s42, v111
    v_cmp_ne_u32 s[68:69], s42, v115
    s_or_b64 vcc, vcc, s[68:69]
    s_cbranch_vccz L_fok
    s_nop 0
    s_sub_u32 s64, s64, 1
    s_cbranch_scc0 L_fpoll
L_fok:
    v_perm_b32 v119, v108, v109, s57
    v_perm_b32 v123, v112, v113, s57
    v_add_f32 v116, v108, v112
    v_perm_b32 v119, v119, v110, s58
    v_perm_b32 v123, v123, v114, s58
    v_add_f32 v117, v109, v113
    v_add_f32 v118, v110, v114
    v_add_f32 v119, v119, v123
    v_add_f32_dpp v116, v116, v116 quad_perm:[2,3,0,1] row_mask:0xf bank_mask:0xf
    v_add_f32_dpp v117, v117, v117 quad_perm:[2,3,0,1] row_mask:0xf bank_mask:0xf
    v_add_f32_dpp v118, v118, v118 quad_perm:[2,3,0,1] row_mask:0xf bank_mask:0xf
L_hB_17:
    s_cbranch_execz L_hB_18
    v_add_f32_dpp v119, v119, v119 quad_perm:[2,3,0,1] row_mask:0xf bank_mask:0xf
    v_add_f32_dpp v116, v116, v116 row_ror:4 row_mask:0xf bank_mask:0xf
    v_add_f32_dpp v117, v117, v117 row_ror:4 row_mask:0xf bank_mask:0xf
    v_add_f32_dpp v118, v118, v118 row_ror:4 row_mask:0xf bank_mask:0xf
    v_add_f32_dpp v119, v119, v119 row_ror:4 row_mask:0xf bank_mask:0xf
    v_add_f32_dpp v116, v116, v116 row_ror:8 row_mask:0xf bank_mask:0xf
    v_add_f32_dpp v117, v117, v117 row_ror:8 row_mask:0xf bank_mask:0xf
    v_add_f32_dpp v118, v118, v118 row_ror:8 row_mask:0xf bank_mask:0xf
    v_add_f32_dpp v119, v119, v119 row_ror:8 row_mask:0xf bank_mask:0xf
    s_nop 0
    v_permlane16_swap_b32 v116, v117
    v_permlane16_swap_b32 v118, v119
    s_nop 0
    v_add_f32 v116, v116, v117
    v_add_f32 v118, v118, v119
    s_nop 1
    v_permlane32_swap_b32 v116, v118
    s_nop 0
    v_add_f32 v116, v116, v118
    v_cvt_pk_bf16_f32 v116, v116, v116
    buffer_store_short v116, v38, s[32:35], 0 offen
L_hB_18:
    s_cbranch_execz L_hB_19
    s_cmp_lg_u32 s2, 0
    s_cbranch_scc1 L_fin
    v_mov_b32 v2, s42
    v_mov_b32 v3, 260046848
    s_mov_b64 exec, 1
    buffer_store_dword v2, v3, s[28:31], 0 offen sc1
    s_mov_b64 exec, -1
L_fin:
    s_endpgm
L_qretry:
    s_sub_u32 s64, s64, 1
    s_cbranch_scc1 L_qok
    s_cmp_gt_u32 s64, 99936
    s_cbranch_scc1 L_qre
    s_cmp_lg_u32 s64, 99936
    s_cbranch_scc1 L_qtg
    buffer_store_dwordx4 v[152:155], v24, s[28:31], s65 offen sc1
L_qtg:
    s_xor_b32 s49, s49, 2097152
L_qre:
    buffer_load_dwordx4 v[132:135], v25, s[28:31], s49 offen offset:0 sc1
    buffer_load_dwordx4 v[136:139], v25, s[28:31], s49 offen offset:2048 sc1
    s_waitcnt vmcnt(0)
    s_branch L_qchk
L_oretry:
    s_sub_u32 s64, s64, 1
    s_cbranch_scc1 L_ook
L_hB_19:
    s_cbranch_execz L_warm_doneB
    s_cmp_gt_u32 s64, 99936
    s_cbranch_scc1 L_ore
    s_cmp_lg_u32 s64, 99936
    s_cbranch_scc1 L_otg
    buffer_store_dwordx4 v[152:155], v24, s[28:31], s65 offen sc1
    buffer_store_dwordx4 v[156:159], v32, s[28:31], s66 offen sc1
    buffer_store_dwordx4 v[160:163], v32, s[28:31], s66 offen offset:64 sc1
L_otg:
    s_xor_b32 s50, s50, 2097152
L_ore:
    buffer_load_dwordx4 v[76:79], v33, s[28:31], s50 offen offset:0 sc1
    buffer_load_dwordx4 v[80:83], v33, s[28:31], s50 offen offset:2048 sc1
    s_waitcnt vmcnt(0)
    s_branch L_ochk
L_wf1f:
    buffer_store_dwordx4 v[152:155], v24, s[28:31], s65 offen sc1
    s_movk_i32 s67, 2000
    s_branch L_wf1
L_wf2f:
    buffer_store_dwordx4 v[152:155], v24, s[28:31], s65 offen sc1
    s_movk_i32 s67, 2000
    s_branch L_wf2
L_wf3f:
    buffer_store_dwordx4 v[152:155], v24, s[28:31], s65 offen sc1
    s_movk_i32 s67, 2000
    s_branch L_wf3
L_wf4f:
    buffer_store_dwordx4 v[152:155], v24, s[28:31], s65 offen sc1
    s_movk_i32 s67, 2000
    s_branch L_wf4
L_wf5f:
    buffer_store_dwordx4 v[152:155], v24, s[28:31], s65 offen sc1
    buffer_store_dwordx4 v[156:159], v32, s[28:31], s66 offen sc1
    buffer_store_dwordx4 v[160:163], v32, s[28:31], s66 offen offset:64 sc1
    s_movk_i32 s67, 2000
    s_branch L_wf5
L_wf6f:
    buffer_store_dwordx4 v[152:155], v24, s[28:31], s65 offen sc1
    buffer_store_dwordx4 v[156:159], v32, s[28:31], s66 offen sc1
    buffer_store_dwordx4 v[160:163], v32, s[28:31], s66 offen offset:64 sc1
    s_movk_i32 s67, 2000
    s_branch L_wf6
L_wf7f:
    buffer_store_dwordx4 v[152:155], v24, s[28:31], s65 offen sc1
    buffer_store_dwordx4 v[156:159], v32, s[28:31], s66 offen sc1
    buffer_store_dwordx4 v[160:163], v32, s[28:31], s66 offen offset:64 sc1
    s_movk_i32 s67, 2000
    s_branch L_wf7
L_wf8f:
    buffer_store_dwordx4 v[152:155], v24, s[28:31], s65 offen sc1
    buffer_store_dwordx4 v[156:159], v32, s[28:31], s66 offen sc1
    buffer_store_dwordx4 v[160:163], v32, s[28:31], s66 offen offset:64 sc1
    s_movk_i32 s67, 2000
    s_branch L_wf8
L_tail:
L_end:
    s_endpgm
.section .rodata,"a"
.p2align 6
.amdhsa_kernel standalone__sliding_block_cached__decode_kernel
  .amdhsa_next_free_vgpr 196
  .amdhsa_next_free_sgpr 72
  .amdhsa_accum_offset 196
  .amdhsa_group_segment_fixed_size 0
  .amdhsa_kernarg_size 64
  .amdhsa_user_sgpr_count 2
  .amdhsa_user_sgpr_kernarg_segment_ptr 1
  .amdhsa_system_sgpr_workgroup_id_x 1
.end_amdhsa_kernel
```
